```python
import torch

def _softmax(x, axis=-1):
    return torch.softmax(x, dim=axis)
def _gelu(x):
    return torch.nn.functional.gelu(x, approximate="tanh")
def _silu(x):
    return torch.nn.functional.silu(x)
def _sigmoid(x):
    return torch.sigmoid(x)
def _layernorm(x, axis=-1, eps=1e-5):
    m = x.mean(dim=axis, keepdim=True)
    v = x.var(dim=axis, keepdim=True, unbiased=False)
    return (x - m) / torch.sqrt(v + eps)
def _scatter_add(tgt, idx, src, axis=0):
    return tgt.clone().index_add_(axis, idx, src)
def _segment_sum(src, seg, n):
    out = torch.zeros((n,) + src.shape[1:], dtype=src.dtype)
    return out.index_add_(0, seg, src)
def _pad(x, pw):
    flat = tuple(v for pair in reversed(pw) for v in pair)
    return torch.nn.functional.pad(x, flat)

kernel_name = 'gated_mix__sliding_block_cached__dense_activation_relu__decode'

def setup_inputs():

    _w = (lambda a: (lambda t: t.to(torch.bfloat16) if t.is_floating_point() else t)(torch.as_tensor(a)))
    def _A_setup():
        B, Sq, D = 4, 1, 640
        Hq, Hkv, Sk, Dh = 32, 32, 4096, 192
        assert Hq % Hkv == 0, (Hq, Hkv)
        return {
            "x": _w((lambda *s: torch.randn(*s, dtype=torch.bfloat16) * 0.05)(B, Sq, D)),
            "k_cache": _w((lambda *s: torch.randn(*s, dtype=torch.bfloat16) * 3.2)(B, Hkv, Sk, Dh)),
            "v_cache": _w((lambda *s: torch.randn(*s, dtype=torch.bfloat16) * 1.6)(B, Hkv, Sk, Dh)),
            "wq": _w((lambda *s: torch.randn(*s, dtype=torch.bfloat16) * 3.2)(D, Hq * Dh) * (D ** -0.5)),
            "wo": _w((lambda *s: torch.randn(*s, dtype=torch.bfloat16) * 1.6)(Hq * Dh, D) * ((Hq * Dh) ** -0.5)),
        }
    _A_in = _A_setup()

    def _B_setup():
        B, S, D, Dff = 4, 1, 640, 1536
        return {
            "x": _w((lambda *s: torch.randn(*s, dtype=torch.bfloat16) * 0.05)(B, S, D)),
            "w1": _w((lambda *s: torch.randn(*s, dtype=torch.bfloat16) * 0.05)(D, Dff)),
            "w2": _w((lambda *s: torch.randn(*s, dtype=torch.bfloat16) * 0.05)(Dff, D)),
        }
    _B_in = _B_setup()

    return {
        "A_x": _A_in["x"],
        "A_k_cache": _A_in["k_cache"],
        "A_v_cache": _A_in["v_cache"],
        "A_wq": _A_in["wq"],
        "A_wo": _A_in["wo"],
        "B_x": _B_in["x"],
        "B_w1": _B_in["w1"],
        "B_w2": _B_in["w2"],
        "gate_w": _w((lambda *s: torch.randn(*s, dtype=torch.bfloat16) * 0.05)(640) * 16.0),
    }

def reference(A_x, A_k_cache, A_v_cache, A_wq, A_wo, B_x, B_w1, B_w2, gate_w):
    def _A_ref(x, k_cache, v_cache, wq, wo):
        B, Sq, D = x.shape
        Hq, Dh = 32, 192
        Hkv, Sk = k_cache.shape[1], k_cache.shape[2]
        W = min(4096, max(256, Sk // 4))
        rep = Hq // Hkv
        q = (lambda x, *d: x.permute(*d))((x @ wq).reshape(B, Sq, Hq, Dh), 0, 2, 1, 3)
        k = (lambda x, n, axis: torch.repeat_interleave(x, n, dim=axis))(k_cache[:, :, Sk - W:, :], rep, axis=1)
        v = (lambda x, n, axis: torch.repeat_interleave(x, n, dim=axis))(v_cache[:, :, Sk - W:, :], rep, axis=1)
        scores = torch.einsum("bhqd,bhkd->bhqk", q, k) * (Dh ** -0.5)
        p = _softmax(scores, axis=-1)
        o = torch.einsum("bhqk,bhkd->bhqd", p, v)
        return (lambda x, *d: x.permute(*d))(o, 0, 2, 1, 3).reshape(B, Sq, Hq * Dh) @ wo

    def _B_ref(x, w1, w2):
        h = torch.einsum("bsd,df->bsf", x, w1)
        zero = torch.zeros_like(h)
        h = torch.maximum(h, zero)
        return torch.einsum("bsf,fd->bsd", h, w2)

    x = A_x
    g = _sigmoid((x * gate_w).sum(-1, keepdims=True))
    a = _A_ref(x, A_k_cache, A_v_cache, A_wq, A_wo)
    b = _B_ref(x, B_w1, B_w2)
    return g * a + (1 - g) * b
```

```asm
; @launch grid=(256,1,1) block=(512,1,1) lds=76800
.amdgcn_target "amdgcn-amd-amdhsa--gfx950"
.text
.globl gated_mix__sliding_block_cached__dense_activation_relu__decode_kernel
.p2align 8
.type gated_mix__sliding_block_cached__dense_activation_relu__decode_kernel,@function
gated_mix__sliding_block_cached__dense_activation_relu__decode_kernel:
  s_cmp_ge_u32 s2, 256
  s_cbranch_scc1 L_end
  s_load_dwordx16 s[16:31], s[0:1], 0
  s_load_dwordx8 s[32:39], s[0:1], 64
  s_getpc_b64 s[68:69]
  v_lshrrev_b32 v3, 6, v0
  v_and_b32 v1, 63, v0
  s_and_b32 s4, s2, 7
  v_readfirstlane_b32 s3, v3
  s_lshr_b32 s5, s2, 3
  s_lshl_b32 s4, s4, 2
  s_lshr_b32 s6, s5, 3
  s_add_u32 s4, s4, s6
  s_and_b32 s5, s5, 7
  s_lshr_b32 s6, s5, 1
  s_and_b32 s7, s5, 1
  v_lshrrev_b32 v4, 5, v1
  v_and_b32 v5, 31, v1
  v_min_u32 v5, 29, v5
  v_cmp_gt_u32 vcc, 24, v5
  s_mul_i32 s8, s5, 80
  s_mul_i32 s9, s3, 10
  s_add_u32 s8, s8, s9
  v_add_u32 v6, s8, v4
  v_mov_b32 v7, 3072
  v_mov_b32 v8, 12288
  v_cndmask_b32 v7, v7, v8, vcc
  v_mul_lo_u32 v6, v6, v7
  s_mul_i32 s10, s4, 384
  s_mul_i32 s11, s4, 96
  s_sub_u32 s11, s11, 384
  v_mov_b32 v8, s11
  v_mov_b32 v9, s10
  v_cndmask_b32 v8, v8, v9, vcc
  v_lshl_add_u32 v8, v5, 4, v8
  v_add_u32 v6, v6, v8
  v_lshlrev_b32 v7, 1, v7
  v_lshrrev_b32 v2, 3, v1
  v_mul_u32_u24 v2, 384, v2
  v_and_b32 v9, 7, v1
  v_lshl_add_u32 v2, v9, 4, v2
  s_lshl_b32 s14, s6, 5
  s_add_u32 s14, s14, s4
  s_mul_i32 s14, s14, 1572864
  s_mul_i32 s15, s7, 196608
  s_add_u32 s14, s14, s15
  s_mul_i32 s15, s3, 24576
  s_add_u32 s14, s14, s15
  s_add_u32 s14, s14, 1179648
  s_lshl_b32 s9, s8, 1
  s_mov_b32 s10, 2097152
  s_mov_b32 s42, 201326592
  s_mov_b32 s43, 0x20000
  s_mov_b32 s46, 201326592
  s_mov_b32 s47, 0x20000
  s_waitcnt lgkmcnt(0)
  v_mov_b32 v10, s28
  v_mov_b32 v11, s22
  v_mov_b32 v12, s29
  v_mov_b32 v13, s23
  v_cndmask_b32 v10, v10, v11, vcc
  v_cndmask_b32 v12, v12, v13, vcc
  v_add_co_u32 v212, vcc, v10, v6
  s_load_dword s101, s[38:39], s10
  s_nop 0
  v_addc_co_u32 v213, vcc, 0, v12, vcc
  global_load_dwordx4 v[160:163], v[212:213], off nt
  v_add_co_u32 v214, vcc, v212, v7
  s_load_dwordx4 s[80:83], s[16:17], s9 offset:0
  s_load_dword s96, s[16:17], s9 offset:16
  v_addc_co_u32 v215, vcc, 0, v213, vcc
  global_load_dwordx4 v[164:167], v[214:215], off nt
  v_add_co_u32 v216, vcc, v214, v7
  s_load_dwordx4 s[84:87], s[16:17], s9 offset:1280
  s_load_dword s97, s[16:17], s9 offset:1296
  v_addc_co_u32 v217, vcc, 0, v215, vcc
  global_load_dwordx4 v[168:171], v[216:217], off nt
  v_add_co_u32 v218, vcc, v216, v7
  s_load_dwordx4 s[88:91], s[16:17], s9 offset:2560
  s_load_dword s98, s[16:17], s9 offset:2576
  v_addc_co_u32 v219, vcc, 0, v217, vcc
  global_load_dwordx4 v[172:175], v[218:219], off nt
  v_add_co_u32 v220, vcc, v218, v7
  s_load_dwordx4 s[92:95], s[16:17], s9 offset:3840
  s_load_dword s99, s[16:17], s9 offset:3856
  v_addc_co_u32 v221, vcc, 0, v219, vcc
  global_load_dwordx4 v[176:179], v[220:221], off nt
  s_mov_b32 s40, s18
  s_mov_b32 s41, s19
  s_mov_b32 s44, s20
  s_mov_b32 s45, s21
  s_mov_b32 s48, s38
  s_mov_b32 s49, s39
  s_mov_b32 s50, 805306368
  s_mov_b32 s51, 0x20000
  s_mov_b32 s56, s34
  s_mov_b32 s57, s35
  s_mov_b32 s58, 5120
  s_mov_b32 s59, 0x20000
  s_mov_b32 s60, s24
  s_mov_b32 s61, s25
  s_mov_b32 s62, 7864320
  s_mov_b32 s63, 0x20000
  s_mov_b32 s64, s30
  s_mov_b32 s65, s31
  s_mov_b32 s66, 1966080
  s_mov_b32 s67, 0x20000
  s_and_b32 s68, s68, 0xffffff00
  s_mov_b32 s70, CODE_BYTES
  s_mov_b32 s71, 0x20000
  s_mov_b32 s72, s16
  s_mov_b32 s73, s17
  s_mov_b32 s74, 5120
  s_mov_b32 s75, 0x20000
  s_mov_b32 s76, s32
  s_mov_b32 s77, s33
  s_mov_b32 s78, 1280
  s_mov_b32 s79, 0x20000
  s_add_u32 s15, s14, 0
  buffer_load_dwordx4 v[64:67], v2, s[40:43], s15 offen offset:0 nt
  s_add_u32 s15, s14, 0
  buffer_load_dwordx4 v[68:71], v2, s[40:43], s15 offen offset:128 nt
  s_add_u32 s15, s14, 0
  buffer_load_dwordx4 v[72:75], v2, s[40:43], s15 offen offset:256 nt
  v_lshlrev_b32 v10, 4, v1
  v_add_u32 v11, 1024, v10
  v_mov_b32 v12, 0x7f000000
  v_cmp_gt_u32 vcc, 16, v1
  s_and_b32 s10, s3, 3
  s_mul_i32 s10, s10, 1280
  v_cndmask_b32 v11, v12, v11, vcc
  buffer_load_dwordx4 v[230:233], v10, s[72:75], s10 offen
  buffer_load_dwordx4 v[234:237], v11, s[72:75], s10 offen
  buffer_load_dwordx4 v[238:241], v10, s[76:79], 0 offen
  buffer_load_dwordx4 v[242:245], v11, s[76:79], 0 offen
  s_lshl_b32 s10, s3, 10
  s_add_u32 s10, s10, 1024
  buffer_load_dwordx4 v[16:19], v10, s[68:71], s10 offen
  s_lshl_b32 s100, s4, 3
  s_add_u32 s100, s100, s5
  s_lshl_b32 s100, s100, 12
  v_mov_b32 v11, 76448
  v_mov_b32 v12, 1.0
  ds_write_b32 v11, v12
  v_cmp_eq_u32 vcc, 0, v4
  v_mov_b32 v222, 0x0c0c0706
  v_mov_b32 v223, 0x0c0c0504
  v_mov_b32 v224, 0x07060c0c
  v_mov_b32 v225, 0x05040c0c
  v_cndmask_b32 v222, v222, v223, vcc
  v_cndmask_b32 v223, v224, v225, vcc
  v_cmp_gt_u32 vcc, 24, v5
  v_mov_b32 v224, 384
  v_mov_b32 v225, 1536
  v_cndmask_b32 v224, v224, v225, vcc
  v_mul_lo_u32 v226, v224, v4
  v_mov_b32 v225, 2304
  v_mov_b32 v227, 0
  v_cndmask_b32 v225, v225, v227, vcc
  v_add_u32 v226, v226, v225
  v_lshl_add_u32 v226, v5, 5, v226
  s_mul_i32 s10, s3, 3840
  v_add_u32 v226, s10, v226
  v_lshrrev_b32 v224, 1, v224
  v_add_u32 v227, v226, v224
  v_and_b32 v24, 7, v1
  v_min_u32 v24, 5, v24
  s_mul_i32 s10, s3, 6
  v_add_u32 v24, s10, v24
  v_lshrrev_b32 v25, 3, v1
  v_lshlrev_b32 v25, 12, v25
  v_lshl_add_u32 v25, v24, 4, v25
  v_mul_u32_u24 v26, 0x1556, v24
  v_lshrrev_b32 v26, 16, v26
  v_mul_u32_u24 v27, 12, v26
  v_sub_u32 v27, v24, v27
  v_mul_u32_u24 v28, 528, v26
  v_lshl_add_u32 v28, v27, 3, v28
  v_add_u32 v28, 74624, v28
  v_lshlrev_b32 v27, 3, v24
  v_add_u32 v27, 73728, v27
  v_lshlrev_b32 v26, 2, v26
  v_add_u32 v26, 76432, v26
  v_mov_b32 v29, 76448
  v_and_b32 v30, 16, v1
  v_cmp_eq_u32 vcc, 0, v30
  v_mov_b32 v30, 0
  v_mov_b32 v31, 0xff800000
  v_cndmask_b32 v27, v28, v27, vcc
  v_cndmask_b32 v26, v26, v29, vcc
  v_cndmask_b32 v28, v30, v31, vcc
  v_lshl_add_u32 v27, v4, 2, v27
  s_waitcnt lgkmcnt(0)
  s_add_u32 s8, s101, 1
  s_and_b32 s7, s8, 0xff
  v_mov_b32 v62, s7
  s_mov_b32 s7, 0xffffff00
  s_getreg_b32 s10, hwreg(HW_REG_XCC_ID, 0, 4)
  s_lshl_b32 s10, s10, 8
  v_or_b32 v61, s10, v62
  s_lshl_b32 s12, s4, 7
  s_add_u32 s12, s12, 3145728
  s_lshl_b32 s10, s5, 2
  v_mov_b32 v60, s10
  s_cmp_eq_u32 s3, 0
  s_cselect_b32 s10, 1, 0
  s_mov_b32 s11, 0
  s_mov_b64 exec, s[10:11]
  buffer_store_dword v61, v60, s[48:51], s12 offen sc1
  s_mov_b64 exec, -1
  v_and_b32 v60, 7, v1
  v_lshlrev_b32 v60, 2, v60
  s_waitcnt vmcnt(13)
  s_add_u32 s15, s14, 3072
  buffer_load_dwordx4 v[76:79], v2, s[40:43], s15 offen offset:0 nt
  v_perm_b32 v228, s80, v228, v222
  v_perm_b32 v229, s80, v229, v223
  v_dot2_f32_bf16 v180, v160, v228, 0
  v_dot2_f32_bf16 v181, v160, v229, 0
  v_dot2_f32_bf16 v182, v161, v228, 0
  v_dot2_f32_bf16 v183, v161, v229, 0
  v_dot2_f32_bf16 v184, v162, v228, 0
  v_dot2_f32_bf16 v185, v162, v229, 0
  v_dot2_f32_bf16 v186, v163, v228, 0
  v_dot2_f32_bf16 v187, v163, v229, 0
  v_perm_b32 v228, s84, v228, v222
  v_perm_b32 v229, s84, v229, v223
  v_dot2_f32_bf16 v188, v160, v228, 0
  v_dot2_f32_bf16 v189, v160, v229, 0
  v_dot2_f32_bf16 v190, v161, v228, 0
  v_dot2_f32_bf16 v191, v161, v229, 0
  v_dot2_f32_bf16 v192, v162, v228, 0
  v_dot2_f32_bf16 v193, v162, v229, 0
  v_dot2_f32_bf16 v194, v163, v228, 0
  v_dot2_f32_bf16 v195, v163, v229, 0
  v_perm_b32 v228, s88, v228, v222
  v_perm_b32 v229, s88, v229, v223
  v_dot2_f32_bf16 v196, v160, v228, 0
  v_dot2_f32_bf16 v197, v160, v229, 0
  v_dot2_f32_bf16 v198, v161, v228, 0
  v_dot2_f32_bf16 v199, v161, v229, 0
  v_dot2_f32_bf16 v200, v162, v228, 0
  v_dot2_f32_bf16 v201, v162, v229, 0
  v_dot2_f32_bf16 v202, v163, v228, 0
  v_dot2_f32_bf16 v203, v163, v229, 0
  v_perm_b32 v228, s92, v228, v222
  v_perm_b32 v229, s92, v229, v223
  v_dot2_f32_bf16 v204, v160, v228, 0
  v_dot2_f32_bf16 v205, v160, v229, 0
  v_dot2_f32_bf16 v206, v161, v228, 0
  v_dot2_f32_bf16 v207, v161, v229, 0
  v_dot2_f32_bf16 v208, v162, v228, 0
  v_dot2_f32_bf16 v209, v162, v229, 0
  v_dot2_f32_bf16 v210, v163, v228, 0
  v_dot2_f32_bf16 v211, v163, v229, 0
  s_waitcnt vmcnt(13)
  s_add_u32 s15, s14, 3072
  buffer_load_dwordx4 v[80:83], v2, s[40:43], s15 offen offset:128 nt
  v_perm_b32 v228, s81, v228, v222
  v_perm_b32 v229, s81, v229, v223
  v_dot2c_f32_bf16 v180, v164, v228
  v_dot2c_f32_bf16 v181, v164, v229
  v_dot2c_f32_bf16 v182, v165, v228
  v_dot2c_f32_bf16 v183, v165, v229
  v_dot2c_f32_bf16 v184, v166, v228
  v_dot2c_f32_bf16 v185, v166, v229
  v_dot2c_f32_bf16 v186, v167, v228
  v_dot2c_f32_bf16 v187, v167, v229
  v_perm_b32 v228, s85, v228, v222
  v_perm_b32 v229, s85, v229, v223
  v_dot2c_f32_bf16 v188, v164, v228
  v_dot2c_f32_bf16 v189, v164, v229
  v_dot2c_f32_bf16 v190, v165, v228
  v_dot2c_f32_bf16 v191, v165, v229
  v_dot2c_f32_bf16 v192, v166, v228
  v_dot2c_f32_bf16 v193, v166, v229
  v_dot2c_f32_bf16 v194, v167, v228
  v_dot2c_f32_bf16 v195, v167, v229
  v_perm_b32 v228, s89, v228, v222
  v_perm_b32 v229, s89, v229, v223
  v_dot2c_f32_bf16 v196, v164, v228
  v_dot2c_f32_bf16 v197, v164, v229
  v_dot2c_f32_bf16 v198, v165, v228
  v_dot2c_f32_bf16 v199, v165, v229
  v_dot2c_f32_bf16 v200, v166, v228
  v_dot2c_f32_bf16 v201, v166, v229
  v_dot2c_f32_bf16 v202, v167, v228
  v_dot2c_f32_bf16 v203, v167, v229
  v_perm_b32 v228, s93, v228, v222
  v_perm_b32 v229, s93, v229, v223
  v_dot2c_f32_bf16 v204, v164, v228
  v_dot2c_f32_bf16 v205, v164, v229
  v_dot2c_f32_bf16 v206, v165, v228
  v_dot2c_f32_bf16 v207, v165, v229
  v_dot2c_f32_bf16 v208, v166, v228
  v_dot2c_f32_bf16 v209, v166, v229
  v_dot2c_f32_bf16 v210, v167, v228
  v_dot2c_f32_bf16 v211, v167, v229
  s_waitcnt vmcnt(13)
  s_add_u32 s15, s14, 3072
  buffer_load_dwordx4 v[84:87], v2, s[40:43], s15 offen offset:256 nt
  v_perm_b32 v228, s82, v228, v222
  v_perm_b32 v229, s82, v229, v223
  v_dot2c_f32_bf16 v180, v168, v228
  v_dot2c_f32_bf16 v181, v168, v229
  v_dot2c_f32_bf16 v182, v169, v228
  v_dot2c_f32_bf16 v183, v169, v229
  v_dot2c_f32_bf16 v184, v170, v228
  v_dot2c_f32_bf16 v185, v170, v229
  v_dot2c_f32_bf16 v186, v171, v228
  v_dot2c_f32_bf16 v187, v171, v229
  v_perm_b32 v228, s86, v228, v222
  v_perm_b32 v229, s86, v229, v223
  v_dot2c_f32_bf16 v188, v168, v228
  v_dot2c_f32_bf16 v189, v168, v229
  v_dot2c_f32_bf16 v190, v169, v228
  v_dot2c_f32_bf16 v191, v169, v229
  v_dot2c_f32_bf16 v192, v170, v228
  v_dot2c_f32_bf16 v193, v170, v229
  v_dot2c_f32_bf16 v194, v171, v228
  v_dot2c_f32_bf16 v195, v171, v229
  v_perm_b32 v228, s90, v228, v222
  v_perm_b32 v229, s90, v229, v223
  v_dot2c_f32_bf16 v196, v168, v228
  v_dot2c_f32_bf16 v197, v168, v229
  v_dot2c_f32_bf16 v198, v169, v228
  v_dot2c_f32_bf16 v199, v169, v229
  v_dot2c_f32_bf16 v200, v170, v228
  v_dot2c_f32_bf16 v201, v170, v229
  v_dot2c_f32_bf16 v202, v171, v228
  v_dot2c_f32_bf16 v203, v171, v229
  v_perm_b32 v228, s94, v228, v222
  v_perm_b32 v229, s94, v229, v223
  v_dot2c_f32_bf16 v204, v168, v228
  v_dot2c_f32_bf16 v205, v168, v229
  v_dot2c_f32_bf16 v206, v169, v228
  v_dot2c_f32_bf16 v207, v169, v229
  v_dot2c_f32_bf16 v208, v170, v228
  v_dot2c_f32_bf16 v209, v170, v229
  v_dot2c_f32_bf16 v210, v171, v228
  v_dot2c_f32_bf16 v211, v171, v229
  s_waitcnt vmcnt(13)
  s_add_u32 s15, s14, 6144
  buffer_load_dwordx4 v[88:91], v2, s[40:43], s15 offen offset:0 nt
  v_perm_b32 v228, s83, v228, v222
  v_perm_b32 v229, s83, v229, v223
  v_dot2c_f32_bf16 v180, v172, v228
  v_dot2c_f32_bf16 v181, v172, v229
  v_dot2c_f32_bf16 v182, v173, v228
  v_dot2c_f32_bf16 v183, v173, v229
  v_dot2c_f32_bf16 v184, v174, v228
  v_dot2c_f32_bf16 v185, v174, v229
  v_dot2c_f32_bf16 v186, v175, v228
  v_dot2c_f32_bf16 v187, v175, v229
  v_perm_b32 v228, s87, v228, v222
  v_perm_b32 v229, s87, v229, v223
  v_dot2c_f32_bf16 v188, v172, v228
  v_dot2c_f32_bf16 v189, v172, v229
  v_dot2c_f32_bf16 v190, v173, v228
  v_dot2c_f32_bf16 v191, v173, v229
  v_dot2c_f32_bf16 v192, v174, v228
  v_dot2c_f32_bf16 v193, v174, v229
  v_dot2c_f32_bf16 v194, v175, v228
  v_dot2c_f32_bf16 v195, v175, v229
  v_perm_b32 v228, s91, v228, v222
  v_perm_b32 v229, s91, v229, v223
  v_dot2c_f32_bf16 v196, v172, v228
  v_dot2c_f32_bf16 v197, v172, v229
  v_dot2c_f32_bf16 v198, v173, v228
  v_dot2c_f32_bf16 v199, v173, v229
  v_dot2c_f32_bf16 v200, v174, v228
  v_dot2c_f32_bf16 v201, v174, v229
  v_dot2c_f32_bf16 v202, v175, v228
  v_dot2c_f32_bf16 v203, v175, v229
  v_perm_b32 v228, s95, v228, v222
  v_perm_b32 v229, s95, v229, v223
  v_dot2c_f32_bf16 v204, v172, v228
  v_dot2c_f32_bf16 v205, v172, v229
  v_dot2c_f32_bf16 v206, v173, v228
  v_dot2c_f32_bf16 v207, v173, v229
  v_dot2c_f32_bf16 v208, v174, v228
  v_dot2c_f32_bf16 v209, v174, v229
  v_dot2c_f32_bf16 v210, v175, v228
  v_dot2c_f32_bf16 v211, v175, v229
  s_waitcnt vmcnt(13)
  s_add_u32 s15, s14, 6144
  buffer_load_dwordx4 v[92:95], v2, s[40:43], s15 offen offset:128 nt
  s_cmp_eq_u32 s3, 0
  s_cselect_b32 s10, 0xff, 0
  s_mov_b32 s11, 0
  s_mov_b64 exec, s[10:11]
  buffer_load_dword v60, v60, s[48:51], s12 offen sc1
  s_mov_b64 exec, -1
  v_perm_b32 v228, s96, v228, v222
  v_perm_b32 v229, s96, v229, v223
  v_dot2c_f32_bf16 v180, v176, v228
  v_dot2c_f32_bf16 v181, v176, v229
  v_dot2c_f32_bf16 v182, v177, v228
  v_dot2c_f32_bf16 v183, v177, v229
  v_dot2c_f32_bf16 v184, v178, v228
  v_dot2c_f32_bf16 v185, v178, v229
  v_dot2c_f32_bf16 v186, v179, v228
  v_dot2c_f32_bf16 v187, v179, v229
  v_perm_b32 v228, s97, v228, v222
  v_perm_b32 v229, s97, v229, v223
  v_dot2c_f32_bf16 v188, v176, v228
  v_dot2c_f32_bf16 v189, v176, v229
  v_dot2c_f32_bf16 v190, v177, v228
  v_dot2c_f32_bf16 v191, v177, v229
  v_dot2c_f32_bf16 v192, v178, v228
  v_dot2c_f32_bf16 v193, v178, v229
  v_dot2c_f32_bf16 v194, v179, v228
  v_dot2c_f32_bf16 v195, v179, v229
  v_perm_b32 v228, s98, v228, v222
  v_perm_b32 v229, s98, v229, v223
  v_dot2c_f32_bf16 v196, v176, v228
  v_dot2c_f32_bf16 v197, v176, v229
  v_dot2c_f32_bf16 v198, v177, v228
  v_dot2c_f32_bf16 v199, v177, v229
  v_dot2c_f32_bf16 v200, v178, v228
  v_dot2c_f32_bf16 v201, v178, v229
  v_dot2c_f32_bf16 v202, v179, v228
  v_dot2c_f32_bf16 v203, v179, v229
  v_perm_b32 v228, s99, v228, v222
  v_perm_b32 v229, s99, v229, v223
  v_dot2c_f32_bf16 v204, v176, v228
  v_dot2c_f32_bf16 v205, v176, v229
  v_dot2c_f32_bf16 v206, v177, v228
  v_dot2c_f32_bf16 v207, v177, v229
  v_dot2c_f32_bf16 v208, v178, v228
  v_dot2c_f32_bf16 v209, v178, v229
  v_dot2c_f32_bf16 v210, v179, v228
  v_dot2c_f32_bf16 v211, v179, v229
  s_waitcnt vmcnt(8)
  v_dot2_f32_bf16 v228, v230, v238, 0
  v_dot2_f32_bf16 v228, v231, v239, v228
  v_dot2_f32_bf16 v228, v232, v240, v228
  v_dot2_f32_bf16 v228, v233, v241, v228
  v_dot2_f32_bf16 v228, v234, v242, v228
  v_dot2_f32_bf16 v228, v235, v243, v228
  v_dot2_f32_bf16 v228, v236, v244, v228
  v_dot2_f32_bf16 v228, v237, v245, v228
  v_permlane32_swap_b32 v180, v196
  v_permlane32_swap_b32 v181, v197
  v_permlane32_swap_b32 v182, v198
  v_permlane32_swap_b32 v183, v199
  v_permlane32_swap_b32 v184, v200
  v_permlane32_swap_b32 v185, v201
  v_permlane32_swap_b32 v186, v202
  v_permlane32_swap_b32 v187, v203
  v_permlane32_swap_b32 v188, v204
  v_permlane32_swap_b32 v189, v205
  v_permlane32_swap_b32 v190, v206
  v_permlane32_swap_b32 v191, v207
  v_permlane32_swap_b32 v192, v208
  v_permlane32_swap_b32 v193, v209
  v_permlane32_swap_b32 v194, v210
  v_permlane32_swap_b32 v195, v211
  v_add_f32 v180, v180, v196
  v_add_f32_dpp v228, v228, v228 row_shr:1 row_mask:0xf bank_mask:0xf bound_ctrl:0
  v_add_f32 v181, v181, v197
  v_add_f32 v182, v182, v198
  v_add_f32 v183, v183, v199
  v_add_f32_dpp v228, v228, v228 row_shr:2 row_mask:0xf bank_mask:0xf bound_ctrl:0
  v_add_f32 v184, v184, v200
  v_add_f32 v185, v185, v201
  v_add_f32 v186, v186, v202
  v_add_f32_dpp v228, v228, v228 row_shr:4 row_mask:0xf bank_mask:0xf bound_ctrl:0
  v_add_f32 v187, v187, v203
  v_add_f32 v188, v188, v204
  v_add_f32 v189, v189, v205
  v_add_f32_dpp v228, v228, v228 row_shr:8 row_mask:0xf bank_mask:0xf bound_ctrl:0
  v_add_f32 v190, v190, v206
  v_add_f32 v191, v191, v207
  v_add_f32 v192, v192, v208
  v_add_f32_dpp v228, v228, v228 row_bcast:15 row_mask:0xa bank_mask:0xf
  v_add_f32 v193, v193, v209
  v_add_f32 v194, v194, v210
  v_add_f32 v195, v195, v211
  v_add_f32_dpp v228, v228, v228 row_bcast:31 row_mask:0xc bank_mask:0xf
  ds_write_b128 v226, v[180:183]
  ds_write_b128 v226, v[184:187] offset:16
  v_readlane_b32 s10, v228, 63
  v_mov_b32 v229, 0xbfb8aa3b
  ds_write_b128 v227, v[188:191]
  ds_write_b128 v227, v[192:195] offset:16
  v_mul_f32 v228, s10, v229
  v_exp_f32 v228, v228
  s_and_b32 s10, s3, 3
  s_lshl_b32 s10, s10, 2
  v_add_f32 v228, 1.0, v228
  v_rcp_f32 v228, v228
  s_add_u32 s10, s10, 76416
  v_mov_b32 v230, s10
  v_sub_f32 v229, 1.0, v228
  ds_write_b32 v230, v228
  ds_write_b32 v230, v229 offset:16
  s_cmp_lg_u32 s3, 0
  s_cbranch_scc1 L_noverdict
  s_waitcnt vmcnt(0)
  s_mov_b64 exec, 0xff
  v_cmp_eq_u32 vcc, v60, v61
  s_cmp_eq_u64 vcc, exec
  s_cselect_b32 s10, 1, 0
  s_mov_b64 exec, -1
  v_mov_b32 v60, s10
  v_mov_b32 v61, 76456
  ds_write_b32 v61, v60
L_noverdict:
  s_mul_i32 s10, s3, 480
  v_add_u32 v228, s10, v10
  v_mov_b32 v61, 76456
  s_waitcnt lgkmcnt(0)
  s_barrier
  ds_read_b32 v60, v61
  ds_read_b32 v26, v26
  s_mov_b64 exec, 0x3fffffff
  ds_read_b128 v[160:163], v228 offset:0
  ds_read_b128 v[164:167], v228 offset:3840
  ds_read_b128 v[168:171], v228 offset:7680
  ds_read_b128 v[172:175], v228 offset:11520
  ds_read_b128 v[176:179], v228 offset:15360
  ds_read_b128 v[180:183], v228 offset:19200
  ds_read_b128 v[184:187], v228 offset:23040
  ds_read_b128 v[188:191], v228 offset:26880
  s_waitcnt lgkmcnt(6)
  v_add_f32 v160, v160, v164
  v_add_f32 v161, v161, v165
  v_add_f32 v162, v162, v166
  v_add_f32 v163, v163, v167
  s_waitcnt lgkmcnt(5)
  v_add_f32 v160, v160, v168
  v_add_f32 v161, v161, v169
  v_add_f32 v162, v162, v170
  v_add_f32 v163, v163, v171
  s_waitcnt lgkmcnt(4)
  v_add_f32 v160, v160, v172
  v_add_f32 v161, v161, v173
  v_add_f32 v162, v162, v174
  v_add_f32 v163, v163, v175
  s_waitcnt lgkmcnt(3)
  v_add_f32 v160, v160, v176
  v_add_f32 v161, v161, v177
  v_add_f32 v162, v162, v178
  v_add_f32 v163, v163, v179
  s_waitcnt lgkmcnt(2)
  v_add_f32 v160, v160, v180
  v_add_f32 v161, v161, v181
  v_add_f32 v162, v162, v182
  v_add_f32 v163, v163, v183
  s_waitcnt lgkmcnt(1)
  v_add_f32 v160, v160, v184
  v_add_f32 v161, v161, v185
  v_add_f32 v162, v162, v186
  v_add_f32 v163, v163, v187
  s_waitcnt lgkmcnt(0)
  v_add_f32 v160, v160, v188
  v_add_f32 v161, v161, v189
  v_add_f32 v162, v162, v190
  v_add_f32 v163, v163, v191
  v_readfirstlane_b32 s99, v60
  v_and_or_b32 v160, v160, s7, v62
  v_and_or_b32 v161, v161, s7, v62
  v_and_or_b32 v162, v162, s7, v62
  v_and_or_b32 v163, v163, s7, v62
  s_cmp_eq_u32 s99, 1
  s_cbranch_scc1 L_qplain
  buffer_store_dwordx4 v[160:163], v228, s[48:51], s100 offen sc1
  s_branch L_qstored
L_qplain:
  buffer_store_dwordx4 v[160:163], v228, s[48:51], s100 offen
L_qstored:
  s_mov_b64 exec, -1
  s_waitcnt vmcnt(5)
  s_add_u32 s15, s14, 6144
  buffer_load_dwordx4 v[96:99], v2, s[40:43], s15 offen offset:256 nt
  s_waitcnt vmcnt(5)
  s_add_u32 s15, s14, 9216
  buffer_load_dwordx4 v[100:103], v2, s[40:43], s15 offen offset:0 nt
  s_waitcnt vmcnt(5)
  s_add_u32 s15, s14, 9216
  buffer_load_dwordx4 v[104:107], v2, s[40:43], s15 offen offset:128 nt
  s_waitcnt vmcnt(5)
  s_add_u32 s15, s14, 9216
  buffer_load_dwordx4 v[108:111], v2, s[40:43], s15 offen offset:256 nt
  s_waitcnt vmcnt(5)
  s_add_u32 s15, s14, 12288
  buffer_load_dwordx4 v[112:115], v2, s[40:43], s15 offen offset:0 nt
  s_waitcnt vmcnt(5)
  s_add_u32 s15, s14, 12288
  buffer_load_dwordx4 v[116:119], v2, s[40:43], s15 offen offset:128 nt
  s_lshl_b32 s10, s4, 15
  s_mul_i32 s11, s6, 768
  s_add_u32 s11, s11, s10
  s_cmp_eq_u32 s99, 1
  s_cbranch_scc1 L_gfast
  buffer_load_dwordx4 v[8:11], v25, s[48:51], s11 offen sc1
  buffer_load_dwordx4 v[12:15], v25, s[48:51], s10 offen offset:3072 sc1
  s_branch L_gdone
L_gfast:
  buffer_load_dwordx4 v[8:11], v25, s[48:51], s11 offen nt
  buffer_load_dwordx4 v[12:15], v25, s[48:51], s10 offen offset:3072 nt
L_gdone:
  s_waitcnt vmcnt(5)
  s_add_u32 s15, s14, 12288
  buffer_load_dwordx4 v[120:123], v2, s[40:43], s15 offen offset:256 nt
  s_waitcnt vmcnt(5)
  s_add_u32 s15, s14, 15360
  buffer_load_dwordx4 v[124:127], v2, s[40:43], s15 offen offset:0 nt
  s_waitcnt vmcnt(5)
  s_add_u32 s15, s14, 15360
  buffer_load_dwordx4 v[128:131], v2, s[40:43], s15 offen offset:128 nt
  s_waitcnt vmcnt(5)
  s_add_u32 s15, s14, 15360
  buffer_load_dwordx4 v[132:135], v2, s[40:43], s15 offen offset:256 nt
  s_waitcnt vmcnt(5)
  s_add_u32 s15, s14, 18432
  buffer_load_dwordx4 v[136:139], v2, s[40:43], s15 offen offset:0 nt
  s_waitcnt vmcnt(5)
  s_mov_b32 s101, 262144
L_spinq:
  v_bitop3_b32 v16, v8, v9, v62 bitop3:0x7e
  v_bitop3_b32 v17, v10, v11, v62 bitop3:0x7e
  v_bitop3_b32 v18, v12, v13, v62 bitop3:0x7e
  v_bitop3_b32 v19, v14, v15, v62 bitop3:0x7e
  v_or3_b32 v16, v16, v17, v18
  v_or_b32 v16, v16, v19
  v_and_b32 v16, 0xff, v16
  v_cmp_eq_u32 vcc, 0, v16
  s_cmp_eq_u64 vcc, exec
  s_cbranch_scc1 L_qready
  s_sleep 4
  buffer_load_dwordx4 v[8:11], v25, s[48:51], s11 offen sc1
  buffer_load_dwordx4 v[12:15], v25, s[48:51], s10 offen offset:3072 sc1
  s_waitcnt vmcnt(0)
  s_sub_u32 s101, s101, 1
  s_cmp_lg_u32 s101, 0
  s_cbranch_scc1 L_spinq
L_qready:
  v_and_b32 v8, s7, v8
  v_and_b32 v9, s7, v9
  v_and_b32 v10, s7, v10
  v_and_b32 v11, s7, v11
  v_and_b32 v12, s7, v12
  v_and_b32 v13, s7, v13
  v_and_b32 v14, s7, v14
  v_and_b32 v15, s7, v15
  s_add_u32 s15, s14, 18432
  buffer_load_dwordx4 v[140:143], v2, s[40:43], s15 offen offset:128 nt
  v_add_f32_dpp v8, v8, v8 row_ror:8 row_mask:0xf bank_mask:0xf
  v_add_f32_dpp v9, v9, v9 row_ror:8 row_mask:0xf bank_mask:0xf
  v_add_f32_dpp v10, v10, v10 row_ror:8 row_mask:0xf bank_mask:0xf
  v_add_f32_dpp v11, v11, v11 row_ror:8 row_mask:0xf bank_mask:0xf
  v_add_f32_dpp v12, v12, v12 row_ror:8 row_mask:0xf bank_mask:0xf
  v_add_f32_dpp v13, v13, v13 row_ror:8 row_mask:0xf bank_mask:0xf
  v_add_f32_dpp v14, v14, v14 row_ror:8 row_mask:0xf bank_mask:0xf
  v_add_f32_dpp v15, v15, v15 row_ror:8 row_mask:0xf bank_mask:0xf
  s_nop 0
  v_permlane16_swap_b32 v8, v12
  v_permlane16_swap_b32 v9, v13
  v_permlane16_swap_b32 v10, v14
  v_permlane16_swap_b32 v11, v15
  s_nop 0
  v_add_f32 v8, v8, v12
  v_add_f32 v9, v9, v13
  v_add_f32 v10, v10, v14
  v_add_f32 v11, v11, v15
  s_nop 0
  v_permlane32_swap_b32 v8, v10
  v_permlane32_swap_b32 v9, v11
  s_nop 0
  v_add_f32 v8, v8, v10
  v_add_f32 v9, v9, v11
  v_max_f32 v8, v8, v28
  v_max_f32 v9, v9, v28
  v_mul_f32 v8, v8, v26
  v_mul_f32 v9, v9, v26
  v_cvt_pk_bf16_f32 v8, v8, v9
  ds_write_b32 v27, v8
  v_and_b32 v9, 7, v1
  v_lshlrev_b32 v9, 4, v9
  v_add_u32 v9, 73728, v9
  s_waitcnt lgkmcnt(0)
  s_barrier
  ds_read_b128 v[32:35], v9 offset:0
  ds_read_b128 v[36:39], v9 offset:128
  ds_read_b128 v[40:43], v9 offset:256
  s_waitcnt vmcnt(5)
  s_add_u32 s15, s14, 18432
  buffer_load_dwordx4 v[144:147], v2, s[40:43], s15 offen offset:256 nt
  s_waitcnt vmcnt(5)
  s_add_u32 s15, s14, 21504
  buffer_load_dwordx4 v[148:151], v2, s[40:43], s15 offen offset:0 nt
  s_waitcnt lgkmcnt(0)
  s_waitcnt vmcnt(29)
  v_dot2_f32_bf16 v44, v64, v32, 0
  v_dot2_f32_bf16 v44, v65, v33, v44
  v_dot2_f32_bf16 v44, v66, v34, v44
  v_dot2_f32_bf16 v44, v67, v35, v44
  v_dot2_f32_bf16 v44, v68, v36, v44
  v_dot2_f32_bf16 v44, v69, v37, v44
  v_dot2_f32_bf16 v44, v70, v38, v44
  v_dot2_f32_bf16 v44, v71, v39, v44
  v_dot2_f32_bf16 v44, v72, v40, v44
  v_dot2_f32_bf16 v44, v73, v41, v44
  v_dot2_f32_bf16 v44, v74, v42, v44
  v_dot2_f32_bf16 v44, v75, v43, v44
  s_waitcnt vmcnt(20)
  v_dot2_f32_bf16 v45, v76, v32, 0
  v_dot2_f32_bf16 v45, v77, v33, v45
  v_dot2_f32_bf16 v45, v78, v34, v45
  v_dot2_f32_bf16 v45, v79, v35, v45
  v_dot2_f32_bf16 v45, v80, v36, v45
  v_dot2_f32_bf16 v45, v81, v37, v45
  v_dot2_f32_bf16 v45, v82, v38, v45
  v_dot2_f32_bf16 v45, v83, v39, v45
  v_dot2_f32_bf16 v45, v84, v40, v45
  v_dot2_f32_bf16 v45, v85, v41, v45
  v_dot2_f32_bf16 v45, v86, v42, v45
  v_dot2_f32_bf16 v45, v87, v43, v45
  s_waitcnt vmcnt(15)
  v_dot2_f32_bf16 v46, v88, v32, 0
  v_dot2_f32_bf16 v46, v89, v33, v46
  v_dot2_f32_bf16 v46, v90, v34, v46
  v_dot2_f32_bf16 v46, v91, v35, v46
  v_dot2_f32_bf16 v46, v92, v36, v46
  v_dot2_f32_bf16 v46, v93, v37, v46
  v_dot2_f32_bf16 v46, v94, v38, v46
  v_dot2_f32_bf16 v46, v95, v39, v46
  v_dot2_f32_bf16 v46, v96, v40, v46
  v_dot2_f32_bf16 v46, v97, v41, v46
  v_dot2_f32_bf16 v46, v98, v42, v46
  v_dot2_f32_bf16 v46, v99, v43, v46
  s_waitcnt vmcnt(12)
  v_dot2_f32_bf16 v47, v100, v32, 0
  v_dot2_f32_bf16 v47, v101, v33, v47
  v_dot2_f32_bf16 v47, v102, v34, v47
  v_dot2_f32_bf16 v47, v103, v35, v47
  v_dot2_f32_bf16 v47, v104, v36, v47
  v_dot2_f32_bf16 v47, v105, v37, v47
  v_dot2_f32_bf16 v47, v106, v38, v47
  v_dot2_f32_bf16 v47, v107, v39, v47
  v_dot2_f32_bf16 v47, v108, v40, v47
  v_dot2_f32_bf16 v47, v109, v41, v47
  v_dot2_f32_bf16 v47, v110, v42, v47
  v_dot2_f32_bf16 v47, v111, v43, v47
  s_waitcnt vmcnt(7)
  v_dot2_f32_bf16 v48, v112, v32, 0
  v_dot2_f32_bf16 v48, v113, v33, v48
  v_dot2_f32_bf16 v48, v114, v34, v48
  v_dot2_f32_bf16 v48, v115, v35, v48
  v_dot2_f32_bf16 v48, v116, v36, v48
  v_dot2_f32_bf16 v48, v117, v37, v48
  v_dot2_f32_bf16 v48, v118, v38, v48
  v_dot2_f32_bf16 v48, v119, v39, v48
  v_dot2_f32_bf16 v48, v120, v40, v48
  v_dot2_f32_bf16 v48, v121, v41, v48
  v_dot2_f32_bf16 v48, v122, v42, v48
  v_dot2_f32_bf16 v48, v123, v43, v48
  s_waitcnt vmcnt(4)
  s_add_u32 s15, s14, 21504
  buffer_load_dwordx4 v[152:155], v2, s[40:43], s15 offen offset:128 nt
  s_add_u32 s15, s14, 21504
  buffer_load_dwordx4 v[156:159], v2, s[40:43], s15 offen offset:256 nt
  v_dot2_f32_bf16 v49, v124, v32, 0
  v_dot2_f32_bf16 v49, v125, v33, v49
  v_dot2_f32_bf16 v49, v126, v34, v49
  v_dot2_f32_bf16 v49, v127, v35, v49
  v_dot2_f32_bf16 v49, v128, v36, v49
  v_dot2_f32_bf16 v49, v129, v37, v49
  v_dot2_f32_bf16 v49, v130, v38, v49
  v_dot2_f32_bf16 v49, v131, v39, v49
  v_dot2_f32_bf16 v49, v132, v40, v49
  v_dot2_f32_bf16 v49, v133, v41, v49
  v_dot2_f32_bf16 v49, v134, v42, v49
  v_dot2_f32_bf16 v49, v135, v43, v49
  s_waitcnt vmcnt(3)
  s_add_u32 s15, s14, 0
  buffer_load_dwordx4 v[160:163], v2, s[44:47], s15 offen offset:0 nt
  s_add_u32 s15, s14, 0
  buffer_load_dwordx4 v[164:167], v2, s[44:47], s15 offen offset:128 nt
  s_add_u32 s15, s14, 0
  buffer_load_dwordx4 v[168:171], v2, s[44:47], s15 offen offset:256 nt
  v_dot2_f32_bf16 v50, v136, v32, 0
  v_dot2_f32_bf16 v50, v137, v33, v50
  v_dot2_f32_bf16 v50, v138, v34, v50
  v_dot2_f32_bf16 v50, v139, v35, v50
  v_dot2_f32_bf16 v50, v140, v36, v50
  v_dot2_f32_bf16 v50, v141, v37, v50
  v_dot2_f32_bf16 v50, v142, v38, v50
  v_dot2_f32_bf16 v50, v143, v39, v50
  v_dot2_f32_bf16 v50, v144, v40, v50
  v_dot2_f32_bf16 v50, v145, v41, v50
  v_dot2_f32_bf16 v50, v146, v42, v50
  v_dot2_f32_bf16 v50, v147, v43, v50
  s_waitcnt vmcnt(3)
  s_add_u32 s15, s14, 3072
  buffer_load_dwordx4 v[172:175], v2, s[44:47], s15 offen offset:0 nt
  s_add_u32 s15, s14, 3072
  buffer_load_dwordx4 v[176:179], v2, s[44:47], s15 offen offset:128 nt
  s_add_u32 s15, s14, 3072
  buffer_load_dwordx4 v[180:183], v2, s[44:47], s15 offen offset:256 nt
  v_dot2_f32_bf16 v51, v148, v32, 0
  v_dot2_f32_bf16 v51, v149, v33, v51
  v_dot2_f32_bf16 v51, v150, v34, v51
  v_dot2_f32_bf16 v51, v151, v35, v51
  v_dot2_f32_bf16 v51, v152, v36, v51
  v_dot2_f32_bf16 v51, v153, v37, v51
  v_dot2_f32_bf16 v51, v154, v38, v51
  v_dot2_f32_bf16 v51, v155, v39, v51
  v_dot2_f32_bf16 v51, v156, v40, v51
  v_dot2_f32_bf16 v51, v157, v41, v51
  v_dot2_f32_bf16 v51, v158, v42, v51
  v_dot2_f32_bf16 v51, v159, v43, v51
  s_nop 2
  v_add_f32_dpp v44, v44, v44 quad_perm:[1,0,3,2] row_mask:0xf bank_mask:0xf
  v_add_f32_dpp v45, v45, v45 quad_perm:[1,0,3,2] row_mask:0xf bank_mask:0xf
  v_add_f32_dpp v46, v46, v46 quad_perm:[1,0,3,2] row_mask:0xf bank_mask:0xf
  v_add_f32_dpp v47, v47, v47 quad_perm:[1,0,3,2] row_mask:0xf bank_mask:0xf
  v_add_f32_dpp v48, v48, v48 quad_perm:[1,0,3,2] row_mask:0xf bank_mask:0xf
  v_add_f32_dpp v49, v49, v49 quad_perm:[1,0,3,2] row_mask:0xf bank_mask:0xf
  v_add_f32_dpp v50, v50, v50 quad_perm:[1,0,3,2] row_mask:0xf bank_mask:0xf
  v_add_f32_dpp v51, v51, v51 quad_perm:[1,0,3,2] row_mask:0xf bank_mask:0xf
  v_add_f32_dpp v44, v44, v44 quad_perm:[2,3,0,1] row_mask:0xf bank_mask:0xf
  v_add_f32_dpp v45, v45, v45 quad_perm:[2,3,0,1] row_mask:0xf bank_mask:0xf
  v_add_f32_dpp v46, v46, v46 quad_perm:[2,3,0,1] row_mask:0xf bank_mask:0xf
  v_add_f32_dpp v47, v47, v47 quad_perm:[2,3,0,1] row_mask:0xf bank_mask:0xf
  v_add_f32_dpp v48, v48, v48 quad_perm:[2,3,0,1] row_mask:0xf bank_mask:0xf
  v_add_f32_dpp v49, v49, v49 quad_perm:[2,3,0,1] row_mask:0xf bank_mask:0xf
  v_add_f32_dpp v50, v50, v50 quad_perm:[2,3,0,1] row_mask:0xf bank_mask:0xf
  v_add_f32_dpp v51, v51, v51 quad_perm:[2,3,0,1] row_mask:0xf bank_mask:0xf
  v_add_f32_dpp v44, v44, v44 row_half_mirror row_mask:0xf bank_mask:0xf
  v_add_f32_dpp v45, v45, v45 row_half_mirror row_mask:0xf bank_mask:0xf
  v_add_f32_dpp v46, v46, v46 row_half_mirror row_mask:0xf bank_mask:0xf
  v_add_f32_dpp v47, v47, v47 row_half_mirror row_mask:0xf bank_mask:0xf
  v_add_f32_dpp v48, v48, v48 row_half_mirror row_mask:0xf bank_mask:0xf
  v_add_f32_dpp v49, v49, v49 row_half_mirror row_mask:0xf bank_mask:0xf
  v_add_f32_dpp v50, v50, v50 row_half_mirror row_mask:0xf bank_mask:0xf
  v_add_f32_dpp v51, v51, v51 row_half_mirror row_mask:0xf bank_mask:0xf
  v_max3_f32 v8, v44, v45, v46
  v_max3_f32 v9, v47, v48, v49
  v_max3_f32 v8, v8, v50, v51
  v_max_f32 v8, v8, v9
  s_mov_b32 s10, 0x3dd53b95
  s_nop 0
  v_max_f32_dpp v8, v8, v8 row_ror:8 row_mask:0xf bank_mask:0xf
  v_mov_b32 v9, v8
  s_nop 1
  v_permlane16_swap_b32 v8, v9
  s_nop 0
  v_max_f32 v8, v8, v9
  v_mov_b32 v9, v8
  s_nop 1
  v_permlane32_swap_b32 v8, v9
  s_nop 0
  v_max_f32 v8, v8, v9
  v_mul_f32 v8, s10, v8
  v_fma_f32 v44, v44, s10, -v8
  v_fma_f32 v45, v45, s10, -v8
  v_fma_f32 v46, v46, s10, -v8
  v_fma_f32 v47, v47, s10, -v8
  v_fma_f32 v48, v48, s10, -v8
  v_fma_f32 v49, v49, s10, -v8
  v_fma_f32 v50, v50, s10, -v8
  v_fma_f32 v51, v51, s10, -v8
  v_exp_f32 v44, v44
  v_exp_f32 v45, v45
  v_exp_f32 v46, v46
  v_exp_f32 v47, v47
  v_exp_f32 v48, v48
  v_exp_f32 v49, v49
  v_exp_f32 v50, v50
  v_exp_f32 v51, v51
  s_lshl_b32 s10, s3, 2
  s_add_u32 s10, s10, 76352
  v_mov_b32 v14, s10
  v_add_f32 v9, v44, v45
  v_add_f32 v11, v46, v47
  v_add_f32 v12, v48, v49
  v_add_f32 v13, v50, v51
  v_add_f32 v9, v9, v11
  v_add_f32 v12, v12, v13
  v_add_f32 v10, v9, v12
  ds_write_b32 v14, v8
  v_cvt_pk_bf16_f32 v52, 0, v44
  v_cvt_pk_bf16_f32 v53, 0, v45
  v_add_f32_dpp v10, v10, v10 row_ror:8 row_mask:0xf bank_mask:0xf
  v_mov_b32 v9, v10
  v_cvt_pk_bf16_f32 v54, 0, v46
  v_cvt_pk_bf16_f32 v55, 0, v47
  v_permlane16_swap_b32 v10, v9
  v_cvt_pk_bf16_f32 v56, 0, v48
  v_cvt_pk_bf16_f32 v57, 0, v49
  v_add_f32 v10, v10, v9
  v_mov_b32 v9, v10
  v_cvt_pk_bf16_f32 v58, 0, v50
  v_cvt_pk_bf16_f32 v59, 0, v51
  v_permlane32_swap_b32 v10, v9
  v_lshrrev_b32 v44, 16, v52
  v_lshrrev_b32 v45, 16, v53
  v_lshrrev_b32 v46, 16, v54
  v_lshrrev_b32 v47, 16, v55
  v_lshrrev_b32 v48, 16, v56
  v_lshrrev_b32 v49, 16, v57
  v_lshrrev_b32 v50, 16, v58
  v_lshrrev_b32 v51, 16, v59
  v_add_f32 v10, v10, v9
  ds_write_b32 v14, v10 offset:32
  v_and_b32 v64, 7, v1
  v_lshlrev_b32 v64, 5, v64
  v_lshl_add_u32 v64, v4, 4, v64
  v_bfe_u32 v65, v1, 4, 1
  s_mul_i32 s10, s3, 768
  s_add_u32 s10, s10, 0
  v_lshl_add_u32 v64, v65, 3, v64
  v_add_u32 v64, s10, v64
  v_and_b32 v65, 3, v1
  v_mul_u32_u24 v65, 528, v65
  v_lshrrev_b32 v66, 4, v1
  v_lshl_add_u32 v68, v66, 3, v65
  v_add_u32 v68, 74688, v68
  v_lshl_add_u32 v65, v66, 4, v65
  v_add_u32 v65, 74240, v65
  v_bfe_u32 v67, v1, 2, 2
  v_lshl_add_u32 v69, v66, 2, v67
  v_lshl_add_u32 v66, v66, 3, v67
  v_and_b32 v67, 3, v1
  v_lshlrev_b32 v67, 3, v67
  s_lshl_b32 s10, s3, 5
  v_add_u32 v67, s10, v67
  s_movk_i32 s9, 160
  v_mad_u32_u24 v66, v66, s9, v67
  v_mad_u32_u24 v67, v69, s9, v67
  v_add_u32 v66, 32768, v66
  v_add_u32 v67, 70656, v67
  v_lshlrev_b32 v70, 4, v1
  v_mov_b32 v71, 76352
  s_add_u32 s100, s100, 1048576
  s_waitcnt vmcnt(3)
  s_add_u32 s15, s14, 6144
  buffer_load_dwordx4 v[184:187], v2, s[44:47], s15 offen offset:0 nt
  s_add_u32 s15, s14, 6144
  buffer_load_dwordx4 v[188:191], v2, s[44:47], s15 offen offset:128 nt
  s_add_u32 s15, s14, 6144
  buffer_load_dwordx4 v[192:195], v2, s[44:47], s15 offen offset:256 nt
  v_dot2_f32_bf16 v8, v160, v44, 0
  v_dot2_f32_bf16 v9, v160, v52, 0
  v_dot2_f32_bf16 v10, v161, v44, 0
  v_dot2_f32_bf16 v11, v161, v52, 0
  v_dot2_f32_bf16 v12, v162, v44, 0
  v_dot2_f32_bf16 v13, v162, v52, 0
  v_dot2_f32_bf16 v14, v163, v44, 0
  v_dot2_f32_bf16 v15, v163, v52, 0
  v_dot2_f32_bf16 v16, v164, v44, 0
  v_dot2_f32_bf16 v17, v164, v52, 0
  v_dot2_f32_bf16 v18, v165, v44, 0
  v_dot2_f32_bf16 v19, v165, v52, 0
  v_dot2_f32_bf16 v20, v166, v44, 0
  v_dot2_f32_bf16 v21, v166, v52, 0
  v_dot2_f32_bf16 v22, v167, v44, 0
  v_dot2_f32_bf16 v23, v167, v52, 0
  v_dot2_f32_bf16 v24, v168, v44, 0
  v_dot2_f32_bf16 v25, v168, v52, 0
  v_dot2_f32_bf16 v26, v169, v44, 0
  v_dot2_f32_bf16 v27, v169, v52, 0
  v_dot2_f32_bf16 v28, v170, v44, 0
  v_dot2_f32_bf16 v29, v170, v52, 0
  v_dot2_f32_bf16 v30, v171, v44, 0
  v_dot2_f32_bf16 v31, v171, v52, 0
  s_waitcnt vmcnt(3)
  s_add_u32 s15, s14, 9216
  buffer_load_dwordx4 v[196:199], v2, s[44:47], s15 offen offset:0 nt
  s_add_u32 s15, s14, 9216
  buffer_load_dwordx4 v[200:203], v2, s[44:47], s15 offen offset:128 nt
  s_add_u32 s15, s14, 9216
  buffer_load_dwordx4 v[204:207], v2, s[44:47], s15 offen offset:256 nt
  v_dot2c_f32_bf16 v8, v172, v45
  v_dot2c_f32_bf16 v9, v172, v53
  v_dot2c_f32_bf16 v10, v173, v45
  v_dot2c_f32_bf16 v11, v173, v53
  v_dot2c_f32_bf16 v12, v174, v45
  v_dot2c_f32_bf16 v13, v174, v53
  v_dot2c_f32_bf16 v14, v175, v45
  v_dot2c_f32_bf16 v15, v175, v53
  v_dot2c_f32_bf16 v16, v176, v45
  v_dot2c_f32_bf16 v17, v176, v53
  v_dot2c_f32_bf16 v18, v177, v45
  v_dot2c_f32_bf16 v19, v177, v53
  v_dot2c_f32_bf16 v20, v178, v45
  v_dot2c_f32_bf16 v21, v178, v53
  v_dot2c_f32_bf16 v22, v179, v45
  v_dot2c_f32_bf16 v23, v179, v53
  v_dot2c_f32_bf16 v24, v180, v45
  v_dot2c_f32_bf16 v25, v180, v53
  v_dot2c_f32_bf16 v26, v181, v45
  v_dot2c_f32_bf16 v27, v181, v53
  v_dot2c_f32_bf16 v28, v182, v45
  v_dot2c_f32_bf16 v29, v182, v53
  v_dot2c_f32_bf16 v30, v183, v45
  v_dot2c_f32_bf16 v31, v183, v53
  s_cmp_ge_u32 s3, 4
  s_cbranch_scc0 L_noprio2
  s_setprio 1
L_noprio2:
  s_waitcnt vmcnt(3)
  s_add_u32 s15, s14, 12288
  buffer_load_dwordx4 v[208:211], v2, s[44:47], s15 offen offset:0 nt
  s_add_u32 s15, s14, 12288
  buffer_load_dwordx4 v[212:215], v2, s[44:47], s15 offen offset:128 nt
  s_add_u32 s15, s14, 12288
  buffer_load_dwordx4 v[216:219], v2, s[44:47], s15 offen offset:256 nt
  v_dot2c_f32_bf16 v8, v184, v46
  v_dot2c_f32_bf16 v9, v184, v54
  v_dot2c_f32_bf16 v10, v185, v46
  v_dot2c_f32_bf16 v11, v185, v54
  v_dot2c_f32_bf16 v12, v186, v46
  v_dot2c_f32_bf16 v13, v186, v54
  v_dot2c_f32_bf16 v14, v187, v46
  v_dot2c_f32_bf16 v15, v187, v54
  v_dot2c_f32_bf16 v16, v188, v46
  v_dot2c_f32_bf16 v17, v188, v54
  v_dot2c_f32_bf16 v18, v189, v46
  v_dot2c_f32_bf16 v19, v189, v54
  v_dot2c_f32_bf16 v20, v190, v46
  v_dot2c_f32_bf16 v21, v190, v54
  v_dot2c_f32_bf16 v22, v191, v46
  v_dot2c_f32_bf16 v23, v191, v54
  v_dot2c_f32_bf16 v24, v192, v46
  v_dot2c_f32_bf16 v25, v192, v54
  v_dot2c_f32_bf16 v26, v193, v46
  v_dot2c_f32_bf16 v27, v193, v54
  v_dot2c_f32_bf16 v28, v194, v46
  v_dot2c_f32_bf16 v29, v194, v54
  v_dot2c_f32_bf16 v30, v195, v46
  v_dot2c_f32_bf16 v31, v195, v54
  s_waitcnt vmcnt(3)
  s_add_u32 s15, s14, 15360
  buffer_load_dwordx4 v[220:223], v2, s[44:47], s15 offen offset:0 nt
  s_add_u32 s15, s14, 15360
  buffer_load_dwordx4 v[224:227], v2, s[44:47], s15 offen offset:128 nt
  s_add_u32 s15, s14, 15360
  buffer_load_dwordx4 v[228:231], v2, s[44:47], s15 offen offset:256 nt
  s_add_u32 s15, s14, 18432
  buffer_load_dwordx4 v[232:235], v2, s[44:47], s15 offen offset:0 nt
  s_add_u32 s15, s14, 18432
  buffer_load_dwordx4 v[236:239], v2, s[44:47], s15 offen offset:128 nt
  s_add_u32 s15, s14, 18432
  buffer_load_dwordx4 v[240:243], v2, s[44:47], s15 offen offset:256 nt
  s_add_u32 s15, s14, 21504
  buffer_load_dwordx4 v[244:247], v2, s[44:47], s15 offen offset:0 nt
  s_add_u32 s15, s14, 21504
  buffer_load_dwordx4 v[248:251], v2, s[44:47], s15 offen offset:128 nt
  s_add_u32 s15, s14, 21504
  buffer_load_dwordx4 v[252:255], v2, s[44:47], s15 offen offset:256 nt
  s_lshl_b32 s96, s3, 6
  v_add_u32 v3, s96, v1
  s_mul_i32 s96, s4, 245760
  s_mul_i32 s97, s5, 160
  s_add_u32 s96, s96, s97
  s_mul_i32 s98, s4, 61440
  s_add_u32 s97, s97, s98
  s_lshl_b32 s98, s3, 10
  v_mov_b32 v7, 0x7f000000
  v_add_u32 v5, 0, v3
  v_mul_u32_u24 v6, 0x199a, v5
  v_lshrrev_b32 v6, 16, v6
  v_mul_u32_u24 v6, 1120, v6
  v_cmp_gt_u32 vcc, 480, v5
  v_lshl_add_u32 v6, v5, 4, v6
  s_add_u32 m0, s98, 65536
  v_cndmask_b32 v6, v7, v6, vcc
  buffer_load_dwordx4 v6, s[64:67], s97 offen nt lds
  v_add_u32 v5, 0, v3
  v_mul_u32_u24 v6, 0x199a, v5
  v_lshrrev_b32 v6, 16, v6
  v_mul_u32_u24 v6, 1120, v6
  v_cmp_gt_u32 vcc, 1920, v5
  v_lshl_add_u32 v6, v5, 4, v6
  s_add_u32 m0, s98, 32768
  v_cndmask_b32 v6, v7, v6, vcc
  buffer_load_dwordx4 v6, s[60:63], s96 offen nt lds
  v_add_u32 v5, 512, v3
  v_mul_u32_u24 v6, 0x199a, v5
  v_lshrrev_b32 v6, 16, v6
  v_mul_u32_u24 v6, 1120, v6
  v_cmp_gt_u32 vcc, 1920, v5
  v_lshl_add_u32 v6, v5, 4, v6
  s_add_u32 m0, s98, 40960
  v_cndmask_b32 v6, v7, v6, vcc
  buffer_load_dwordx4 v6, s[60:63], s96 offen nt lds
  v_add_u32 v5, 1024, v3
  v_mul_u32_u24 v6, 0x199a, v5
  v_lshrrev_b32 v6, 16, v6
  v_mul_u32_u24 v6, 1120, v6
  v_cmp_gt_u32 vcc, 1920, v5
  v_lshl_add_u32 v6, v5, 4, v6
  s_add_u32 m0, s98, 49152
  v_cndmask_b32 v6, v7, v6, vcc
  buffer_load_dwordx4 v6, s[60:63], s96 offen nt lds
  v_add_u32 v5, 1536, v3
  v_mul_u32_u24 v6, 0x199a, v5
  v_lshrrev_b32 v6, 16, v6
  v_mul_u32_u24 v6, 1120, v6
  v_cmp_gt_u32 vcc, 1920, v5
  v_lshl_add_u32 v6, v5, 4, v6
  s_add_u32 m0, s98, 57344
  v_cndmask_b32 v6, v7, v6, vcc
  buffer_load_dwordx4 v6, s[60:63], s96 offen nt lds
  v_dot2c_f32_bf16 v8, v196, v47
  v_dot2c_f32_bf16 v9, v196, v55
  v_dot2c_f32_bf16 v10, v197, v47
  v_dot2c_f32_bf16 v11, v197, v55
  v_dot2c_f32_bf16 v12, v198, v47
  v_dot2c_f32_bf16 v13, v198, v55
  v_dot2c_f32_bf16 v14, v199, v47
  v_dot2c_f32_bf16 v15, v199, v55
  v_dot2c_f32_bf16 v16, v200, v47
  v_dot2c_f32_bf16 v17, v200, v55
  v_dot2c_f32_bf16 v18, v201, v47
  v_dot2c_f32_bf16 v19, v201, v55
  v_dot2c_f32_bf16 v20, v202, v47
  v_dot2c_f32_bf16 v21, v202, v55
  v_dot2c_f32_bf16 v22, v203, v47
  v_dot2c_f32_bf16 v23, v203, v55
  v_dot2c_f32_bf16 v24, v204, v47
  v_dot2c_f32_bf16 v25, v204, v55
  v_dot2c_f32_bf16 v26, v205, v47
  v_dot2c_f32_bf16 v27, v205, v55
  v_dot2c_f32_bf16 v28, v206, v47
  v_dot2c_f32_bf16 v29, v206, v55
  v_dot2c_f32_bf16 v30, v207, v47
  v_dot2c_f32_bf16 v31, v207, v55
  s_waitcnt vmcnt(14)
  v_dot2c_f32_bf16 v8, v208, v48
  v_dot2c_f32_bf16 v9, v208, v56
  v_dot2c_f32_bf16 v10, v209, v48
  v_dot2c_f32_bf16 v11, v209, v56
  v_dot2c_f32_bf16 v12, v210, v48
  v_dot2c_f32_bf16 v13, v210, v56
  v_dot2c_f32_bf16 v14, v211, v48
  v_dot2c_f32_bf16 v15, v211, v56
  v_dot2c_f32_bf16 v16, v212, v48
  v_dot2c_f32_bf16 v17, v212, v56
  v_dot2c_f32_bf16 v18, v213, v48
  v_dot2c_f32_bf16 v19, v213, v56
  v_dot2c_f32_bf16 v20, v214, v48
  v_dot2c_f32_bf16 v21, v214, v56
  v_dot2c_f32_bf16 v22, v215, v48
  v_dot2c_f32_bf16 v23, v215, v56
  v_dot2c_f32_bf16 v24, v216, v48
  v_dot2c_f32_bf16 v25, v216, v56
  v_dot2c_f32_bf16 v26, v217, v48
  v_dot2c_f32_bf16 v27, v217, v56
  v_dot2c_f32_bf16 v28, v218, v48
  v_dot2c_f32_bf16 v29, v218, v56
  v_dot2c_f32_bf16 v30, v219, v48
  v_dot2c_f32_bf16 v31, v219, v56
  s_waitcnt vmcnt(11)
  v_dot2c_f32_bf16 v8, v220, v49
  v_dot2c_f32_bf16 v9, v220, v57
  v_dot2c_f32_bf16 v10, v221, v49
  v_dot2c_f32_bf16 v11, v221, v57
  v_dot2c_f32_bf16 v12, v222, v49
  v_dot2c_f32_bf16 v13, v222, v57
  v_dot2c_f32_bf16 v14, v223, v49
  v_dot2c_f32_bf16 v15, v223, v57
  v_dot2c_f32_bf16 v16, v224, v49
  v_dot2c_f32_bf16 v17, v224, v57
  v_dot2c_f32_bf16 v18, v225, v49
  v_dot2c_f32_bf16 v19, v225, v57
  v_dot2c_f32_bf16 v20, v226, v49
  v_dot2c_f32_bf16 v21, v226, v57
  v_dot2c_f32_bf16 v22, v227, v49
  v_dot2c_f32_bf16 v23, v227, v57
  v_dot2c_f32_bf16 v24, v228, v49
  v_dot2c_f32_bf16 v25, v228, v57
  v_dot2c_f32_bf16 v26, v229, v49
  v_dot2c_f32_bf16 v27, v229, v57
  v_dot2c_f32_bf16 v28, v230, v49
  v_dot2c_f32_bf16 v29, v230, v57
  v_dot2c_f32_bf16 v30, v231, v49
  v_dot2c_f32_bf16 v31, v231, v57
  s_waitcnt vmcnt(8)
  v_dot2c_f32_bf16 v8, v232, v50
  v_dot2c_f32_bf16 v9, v232, v58
  v_dot2c_f32_bf16 v10, v233, v50
  v_dot2c_f32_bf16 v11, v233, v58
  v_dot2c_f32_bf16 v12, v234, v50
  v_dot2c_f32_bf16 v13, v234, v58
  v_dot2c_f32_bf16 v14, v235, v50
  v_dot2c_f32_bf16 v15, v235, v58
  v_dot2c_f32_bf16 v16, v236, v50
  v_dot2c_f32_bf16 v17, v236, v58
  v_dot2c_f32_bf16 v18, v237, v50
  v_dot2c_f32_bf16 v19, v237, v58
  v_dot2c_f32_bf16 v20, v238, v50
  v_dot2c_f32_bf16 v21, v238, v58
  v_dot2c_f32_bf16 v22, v239, v50
  v_dot2c_f32_bf16 v23, v239, v58
  v_dot2c_f32_bf16 v24, v240, v50
  v_dot2c_f32_bf16 v25, v240, v58
  v_dot2c_f32_bf16 v26, v241, v50
  v_dot2c_f32_bf16 v27, v241, v58
  v_dot2c_f32_bf16 v28, v242, v50
  v_dot2c_f32_bf16 v29, v242, v58
  v_dot2c_f32_bf16 v30, v243, v50
  v_dot2c_f32_bf16 v31, v243, v58
  s_waitcnt vmcnt(5)
  v_dot2c_f32_bf16 v8, v244, v51
  v_dot2c_f32_bf16 v9, v244, v59
  v_dot2c_f32_bf16 v10, v245, v51
  v_dot2c_f32_bf16 v11, v245, v59
  v_dot2c_f32_bf16 v12, v246, v51
  v_dot2c_f32_bf16 v13, v246, v59
  v_dot2c_f32_bf16 v14, v247, v51
  v_dot2c_f32_bf16 v15, v247, v59
  v_dot2c_f32_bf16 v16, v248, v51
  v_dot2c_f32_bf16 v17, v248, v59
  v_dot2c_f32_bf16 v18, v249, v51
  v_dot2c_f32_bf16 v19, v249, v59
  v_dot2c_f32_bf16 v20, v250, v51
  v_dot2c_f32_bf16 v21, v250, v59
  v_dot2c_f32_bf16 v22, v251, v51
  v_dot2c_f32_bf16 v23, v251, v59
  v_dot2c_f32_bf16 v24, v252, v51
  v_dot2c_f32_bf16 v25, v252, v59
  v_dot2c_f32_bf16 v26, v253, v51
  v_dot2c_f32_bf16 v27, v253, v59
  v_dot2c_f32_bf16 v28, v254, v51
  v_dot2c_f32_bf16 v29, v254, v59
  v_dot2c_f32_bf16 v30, v255, v51
  v_dot2c_f32_bf16 v31, v255, v59
  s_setprio 0
  s_nop 1
  v_permlane32_swap_b32 v8, v12
  v_permlane32_swap_b32 v9, v13
  v_permlane32_swap_b32 v10, v14
  v_permlane32_swap_b32 v11, v15
  v_permlane32_swap_b32 v16, v20
  v_permlane32_swap_b32 v17, v21
  v_permlane32_swap_b32 v18, v22
  v_permlane32_swap_b32 v19, v23
  v_permlane32_swap_b32 v24, v28
  v_permlane32_swap_b32 v25, v29
  v_permlane32_swap_b32 v26, v30
  v_permlane32_swap_b32 v27, v31
  v_add_f32 v8, v8, v12
  v_add_f32 v9, v9, v13
  v_add_f32 v10, v10, v14
  v_add_f32 v11, v11, v15
  v_add_f32 v16, v16, v20
  v_add_f32 v17, v17, v21
  v_add_f32 v18, v18, v22
  v_add_f32 v19, v19, v23
  v_add_f32 v24, v24, v28
  v_add_f32 v25, v25, v29
  v_add_f32 v26, v26, v30
  v_add_f32 v27, v27, v31
  v_permlane16_swap_b32 v8, v10
  v_permlane16_swap_b32 v9, v11
  v_permlane16_swap_b32 v16, v18
  v_permlane16_swap_b32 v17, v19
  v_permlane16_swap_b32 v24, v26
  v_permlane16_swap_b32 v25, v27
  v_add_f32 v8, v8, v10
  v_add_f32 v9, v9, v11
  v_add_f32 v16, v16, v18
  v_add_f32 v17, v17, v19
  v_add_f32 v24, v24, v26
  v_add_f32 v25, v25, v27
  v_add_f32_dpp v8, v8, v8 row_ror:8 row_mask:0xf bank_mask:0xf
  v_add_f32_dpp v9, v9, v9 row_ror:8 row_mask:0xf bank_mask:0xf
  ds_write_b64 v64, v[8:9] offset:0
  v_add_f32_dpp v16, v16, v16 row_ror:8 row_mask:0xf bank_mask:0xf
  v_add_f32_dpp v17, v17, v17 row_ror:8 row_mask:0xf bank_mask:0xf
  ds_write_b64 v64, v[16:17] offset:256
  v_add_f32_dpp v24, v24, v24 row_ror:8 row_mask:0xf bank_mask:0xf
  v_add_f32_dpp v25, v25, v25 row_ror:8 row_mask:0xf bank_mask:0xf
  ds_write_b64 v64, v[24:25] offset:512
  s_waitcnt lgkmcnt(0)
  s_barrier
  s_cmp_lg_u32 s3, 7
  s_cbranch_scc1 L_nopub
  ds_read_b128 v[104:107], v71
  ds_read_b128 v[108:111], v71 offset:16
  ds_read_b128 v[112:115], v71 offset:32
  ds_read_b128 v[116:119], v71 offset:48
  ds_read_b128 v[72:75], v70 offset:0
  ds_read_b128 v[76:79], v70 offset:768
  ds_read_b128 v[80:83], v70 offset:1536
  ds_read_b128 v[84:87], v70 offset:2304
  ds_read_b128 v[88:91], v70 offset:3072
  ds_read_b128 v[92:95], v70 offset:3840
  ds_read_b128 v[96:99], v70 offset:4608
  ds_read_b128 v[100:103], v70 offset:5376
  s_mov_b32 s10, -1
  s_mov_b32 s11, 0x1ffff
  v_cmp_eq_u32 vcc, 48, v1
  s_waitcnt lgkmcnt(10)
  v_max3_f32 v120, v104, v105, v106
  v_max3_f32 v121, v107, v108, v109
  v_max3_f32 v120, v120, v110, v111
  v_max_f32 v120, v120, v121
  v_and_b32 v120, s7, v120
  v_sub_f32 v104, v104, v120
  v_sub_f32 v105, v105, v120
  v_sub_f32 v106, v106, v120
  v_sub_f32 v107, v107, v120
  v_sub_f32 v108, v108, v120
  v_sub_f32 v109, v109, v120
  v_sub_f32 v110, v110, v120
  v_sub_f32 v111, v111, v120
  v_exp_f32 v104, v104
  v_exp_f32 v105, v105
  v_exp_f32 v106, v106
  v_exp_f32 v107, v107
  v_exp_f32 v108, v108
  v_exp_f32 v109, v109
  v_exp_f32 v110, v110
  v_exp_f32 v111, v111
  s_waitcnt lgkmcnt(8)
  v_mul_f32 v121, v104, v112
  v_fmac_f32 v121, v105, v113
  v_fmac_f32 v121, v106, v114
  v_fmac_f32 v121, v107, v115
  v_fmac_f32 v121, v108, v116
  v_fmac_f32 v121, v109, v117
  v_fmac_f32 v121, v110, v118
  v_fmac_f32 v121, v111, v119
  s_waitcnt lgkmcnt(7)
  v_mul_f32 v72, v72, v104
  v_mul_f32 v73, v73, v104
  v_mul_f32 v74, v74, v104
  v_mul_f32 v75, v75, v104
  s_waitcnt lgkmcnt(6)
  v_fmac_f32 v72, v76, v105
  v_fmac_f32 v73, v77, v105
  v_fmac_f32 v74, v78, v105
  v_fmac_f32 v75, v79, v105
  s_waitcnt lgkmcnt(5)
  v_fmac_f32 v72, v80, v106
  v_fmac_f32 v73, v81, v106
  v_fmac_f32 v74, v82, v106
  v_fmac_f32 v75, v83, v106
  s_waitcnt lgkmcnt(4)
  v_fmac_f32 v72, v84, v107
  v_fmac_f32 v73, v85, v107
  v_fmac_f32 v74, v86, v107
  v_fmac_f32 v75, v87, v107
  s_waitcnt lgkmcnt(3)
  v_fmac_f32 v72, v88, v108
  v_fmac_f32 v73, v89, v108
  v_fmac_f32 v74, v90, v108
  v_fmac_f32 v75, v91, v108
  s_waitcnt lgkmcnt(2)
  v_fmac_f32 v72, v92, v109
  v_fmac_f32 v73, v93, v109
  v_fmac_f32 v74, v94, v109
  v_fmac_f32 v75, v95, v109
  s_waitcnt lgkmcnt(1)
  v_fmac_f32 v72, v96, v110
  v_fmac_f32 v73, v97, v110
  v_fmac_f32 v74, v98, v110
  v_fmac_f32 v75, v99, v110
  s_waitcnt lgkmcnt(0)
  v_fmac_f32 v72, v100, v111
  v_fmac_f32 v73, v101, v111
  v_fmac_f32 v74, v102, v111
  v_fmac_f32 v75, v103, v111
  v_cndmask_b32 v72, v72, v121, vcc
  v_cndmask_b32 v73, v73, v120, vcc
  s_mov_b64 exec, s[10:11]
  v_and_or_b32 v72, v72, s7, v62
  v_and_or_b32 v73, v73, s7, v62
  v_and_or_b32 v74, v74, s7, v62
  v_and_or_b32 v75, v75, s7, v62
  s_cmp_eq_u32 s99, 1
  s_cbranch_scc1 L_aplain
  buffer_store_dwordx4 v[72:75], v70, s[48:51], s100 offen sc1
  s_branch L_astored
L_aplain:
  buffer_store_dwordx4 v[72:75], v70, s[48:51], s100 offen
L_astored:
  s_mov_b64 exec, -1
L_nopub:
  s_waitcnt vmcnt(0)
  s_barrier
  s_cmp_ge_u32 s3, 5
  s_cbranch_scc1 L_fin_pre
  s_lshl_b32 s10, s4, 15
  s_lshl_b32 s11, s3, 13
  s_add_u32 s10, s10, s11
  s_add_u32 s10, s10, 1048576
  s_mov_b32 s12, -1
  s_mov_b32 s13, 0x1ffff
  s_add_u32 s11, s10, 4096
  s_cmp_eq_u32 s3, 4
  s_cbranch_scc1 L_nog1
  s_mov_b64 exec, s[12:13]
  s_cmp_eq_u32 s99, 1
  s_cbranch_scc1 L_af1
  buffer_load_dwordx4 v[72:75], v70, s[48:51], s10 offen sc1
  buffer_load_dwordx4 v[76:79], v70, s[48:51], s11 offen sc1
  s_branch L_ad1
L_af1:
  buffer_load_dwordx4 v[72:75], v70, s[48:51], s10 offen nt
  buffer_load_dwordx4 v[76:79], v70, s[48:51], s11 offen nt
L_ad1:
  s_mov_b64 exec, -1
L_nog1:
  s_lshl_b32 s15, s3, 2
  s_add_u32 s15, s15, 76416
  v_mov_b32 v71, s15
  ds_read_b32 v71, v71
  ds_read_b128 v[80:83], v65 offset:384
  ds_read_b64 v[84:85], v68
  ds_read_b64_tr_b16 v[120:121], v66 offset:32768
  ds_read_b64_tr_b16 v[122:123], v66 offset:33408
  ds_read_b64_tr_b16 v[124:125], v67
  ds_read_b64_tr_b16 v[96:97], v66 offset:0
  ds_read_b64_tr_b16 v[98:99], v66 offset:640
  ds_read_b64_tr_b16 v[100:101], v66 offset:5120
  ds_read_b64_tr_b16 v[102:103], v66 offset:5760
  ds_read_b64_tr_b16 v[104:105], v66 offset:10240
  ds_read_b64_tr_b16 v[106:107], v66 offset:10880
  ds_read_b64_tr_b16 v[108:109], v66 offset:15360
  ds_read_b64_tr_b16 v[110:111], v66 offset:16000
  ds_read_b64_tr_b16 v[112:113], v66 offset:20480
  ds_read_b64_tr_b16 v[114:115], v66 offset:21120
  ds_read_b64_tr_b16 v[116:117], v66 offset:25600
  ds_read_b64_tr_b16 v[118:119], v66 offset:26240
  s_waitcnt lgkmcnt(12)
  v_mfma_f32_16x16x32_bf16 v[88:91], v[80:83], v[120:123], 0
  v_mfma_f32_16x16x16_bf16 v[92:95], v[84:85], v[124:125], 0
  s_mul_i32 s15, s3, 528
  s_add_u32 s15, s15, 74240
  v_lshrrev_b32 v81, 1, v70
  v_add_u32 v81, s15, v81
  s_cmp_eq_u32 s3, 4
  s_cbranch_scc1 L_b5
  s_mov_b32 s101, 262144
  s_mov_b64 exec, s[12:13]
L_spina:
  s_waitcnt vmcnt(0)
  v_bitop3_b32 v156, v72, v73, v62 bitop3:0x7e
  v_bitop3_b32 v157, v74, v75, v62 bitop3:0x7e
  v_bitop3_b32 v158, v76, v77, v62 bitop3:0x7e
  v_bitop3_b32 v159, v78, v79, v62 bitop3:0x7e
  v_or3_b32 v156, v156, v157, v158
  v_or_b32 v156, v156, v159
  v_and_b32 v156, 0xff, v156
  v_cmp_eq_u32 vcc, 0, v156
  s_cmp_eq_u64 vcc, exec
  s_cbranch_scc1 L_aready
  s_cmp_eq_u32 s99, 1
  s_cbranch_scc1 L_af2
  buffer_load_dwordx4 v[72:75], v70, s[48:51], s10 offen sc1
  buffer_load_dwordx4 v[76:79], v70, s[48:51], s11 offen sc1
  s_branch L_ad2
L_af2:
  buffer_load_dwordx4 v[72:75], v70, s[48:51], s10 offen nt
  buffer_load_dwordx4 v[76:79], v70, s[48:51], s11 offen nt
L_ad2:
  s_sub_u32 s101, s101, 1
  s_cmp_lg_u32 s101, 0
  s_cbranch_scc1 L_spina
L_aready:
  s_mov_b64 exec, -1
  v_and_b32 v73, s7, v73
  v_and_b32 v77, s7, v77
  v_and_b32 v72, s7, v72
  v_and_b32 v76, s7, v76
  v_readlane_b32 s13, v73, 48
  v_readlane_b32 s11, v77, 48
  v_readlane_b32 s12, v72, 48
  v_readlane_b32 s10, v76, 48
  v_mov_b32 v86, s13
  v_max_f32 v87, s11, v86
  v_sub_f32 v86, v86, v87
  v_sub_f32 v87, s11, v87
  v_exp_f32 v86, v86
  v_exp_f32 v87, v87
  v_and_b32 v74, s7, v74
  v_and_b32 v75, s7, v75
  v_and_b32 v78, s7, v78
  v_and_b32 v79, s7, v79
  s_waitcnt lgkmcnt(0)
  v_mul_f32 v80, s12, v86
  v_fmac_f32 v80, s10, v87
  v_rcp_f32 v80, v80
  v_mul_f32 v86, v86, v71
  v_mul_f32 v87, v87, v71
  v_mul_f32 v86, v86, v80
  v_mul_f32 v87, v87, v80
  s_mov_b32 s10, -1
  s_mov_b32 s11, 0xffff
  v_mul_f32 v72, v72, v86
  v_mul_f32 v73, v73, v86
  v_mul_f32 v74, v74, v86
  v_mul_f32 v75, v75, v86
  v_fmac_f32 v72, v76, v87
  v_fmac_f32 v73, v77, v87
  v_fmac_f32 v74, v78, v87
  v_fmac_f32 v75, v79, v87
  v_cvt_pk_bf16_f32 v72, v72, v73
  v_cvt_pk_bf16_f32 v73, v74, v75
  s_mov_b64 exec, s[10:11]
  ds_write_b64 v81, v[72:73]
  s_mov_b64 exec, -1
L_b5:
  s_nop 3
  v_add_f32 v88, v88, v92
  v_add_f32 v89, v89, v93
  v_add_f32 v90, v90, v94
  v_add_f32 v91, v91, v95
  s_lshl_b32 s10, s3, 8
  s_add_u32 s10, s10, s100
  s_waitcnt lgkmcnt(0)
  s_barrier
  ds_read_b128 v[128:131], v65 offset:0
  ds_read_b128 v[132:135], v65 offset:64
  ds_read_b128 v[136:139], v65 offset:128
  ds_read_b128 v[140:143], v65 offset:192
  ds_read_b128 v[144:147], v65 offset:256
  ds_read_b128 v[148:151], v65 offset:320
  s_waitcnt lgkmcnt(5)
  v_mfma_f32_16x16x32_bf16 v[88:91], v[128:131], v[96:99], v[88:91]
  s_waitcnt lgkmcnt(4)
  v_mfma_f32_16x16x32_bf16 v[88:91], v[132:135], v[100:103], v[88:91]
  s_waitcnt lgkmcnt(3)
  v_mfma_f32_16x16x32_bf16 v[88:91], v[136:139], v[104:107], v[88:91]
  s_waitcnt lgkmcnt(2)
  v_mfma_f32_16x16x32_bf16 v[88:91], v[140:143], v[108:111], v[88:91]
  s_waitcnt lgkmcnt(1)
  v_mfma_f32_16x16x32_bf16 v[88:91], v[144:147], v[112:115], v[88:91]
  s_waitcnt lgkmcnt(0)
  v_mfma_f32_16x16x32_bf16 v[88:91], v[148:151], v[116:119], v[88:91]
  s_mov_b64 exec, 0xffff
  s_nop 7
  v_and_or_b32 v88, v88, s7, v62
  v_and_or_b32 v89, v89, s7, v62
  v_and_or_b32 v90, v90, s7, v62
  v_and_or_b32 v91, v91, s7, v62
  buffer_store_dwordx4 v[88:91], v70, s[48:51], s10 offen offset:1024 sc1
  s_mov_b64 exec, -1
  s_branch L_done
L_fin_pre:
  v_and_b32 v73, 31, v1
  s_lshl_b32 s10, s4, 1
  s_add_u32 s10, s10, s3
  s_sub_u32 s10, s10, 5
  s_lshl_b32 s10, s10, 1
  v_add_u32 v74, s10, v4
  v_lshlrev_b32 v73, 15, v73
  v_lshl_add_u32 v73, v74, 4, v73
  s_lshl_b32 s11, s5, 12
  s_add_u32 s11, s11, 1049600
  s_mul_i32 s10, s5, 80
  v_add_lshl_u32 v74, v74, s10, 1
  s_barrier
  s_cmp_eq_u32 s3, 7
  s_cbranch_scc1 L_done
  s_cmp_ge_u32 s4, 20
  s_cbranch_scc1 L_done
  s_mov_b32 s101, 262144
L_spinb:
  buffer_load_dwordx4 v[76:79], v73, s[48:51], s11 offen sc1
  s_waitcnt vmcnt(0)
  v_bitop3_b32 v80, v76, v77, v62 bitop3:0x7e
  v_bitop3_b32 v81, v78, v79, v62 bitop3:0x7e
  v_or_b32 v80, v80, v81
  v_and_b32 v80, 0xff, v80
  v_cmp_eq_u32 vcc, 0, v80
  s_cmp_eq_u64 vcc, exec
  s_cbranch_scc1 L_bready
  s_sub_u32 s101, s101, 1
  s_cmp_lg_u32 s101, 0
  s_cbranch_scc1 L_spinb
L_bready:
  v_and_b32 v76, s7, v76
  v_and_b32 v77, s7, v77
  v_and_b32 v78, s7, v78
  v_and_b32 v79, s7, v79
  v_add_f32_dpp v76, v76, v76 row_shr:1 row_mask:0xf bank_mask:0xf bound_ctrl:0
  v_add_f32_dpp v77, v77, v77 row_shr:1 row_mask:0xf bank_mask:0xf bound_ctrl:0
  v_add_f32_dpp v78, v78, v78 row_shr:1 row_mask:0xf bank_mask:0xf bound_ctrl:0
  v_add_f32_dpp v79, v79, v79 row_shr:1 row_mask:0xf bank_mask:0xf bound_ctrl:0
  v_add_f32_dpp v76, v76, v76 row_shr:2 row_mask:0xf bank_mask:0xf bound_ctrl:0
  v_add_f32_dpp v77, v77, v77 row_shr:2 row_mask:0xf bank_mask:0xf bound_ctrl:0
  v_add_f32_dpp v78, v78, v78 row_shr:2 row_mask:0xf bank_mask:0xf bound_ctrl:0
  v_add_f32_dpp v79, v79, v79 row_shr:2 row_mask:0xf bank_mask:0xf bound_ctrl:0
  v_add_f32_dpp v76, v76, v76 row_shr:4 row_mask:0xf bank_mask:0xf bound_ctrl:0
  v_add_f32_dpp v77, v77, v77 row_shr:4 row_mask:0xf bank_mask:0xf bound_ctrl:0
  v_add_f32_dpp v78, v78, v78 row_shr:4 row_mask:0xf bank_mask:0xf bound_ctrl:0
  v_add_f32_dpp v79, v79, v79 row_shr:4 row_mask:0xf bank_mask:0xf bound_ctrl:0
  v_add_f32_dpp v76, v76, v76 row_shr:8 row_mask:0xf bank_mask:0xf bound_ctrl:0
  v_add_f32_dpp v77, v77, v77 row_shr:8 row_mask:0xf bank_mask:0xf bound_ctrl:0
  v_add_f32_dpp v78, v78, v78 row_shr:8 row_mask:0xf bank_mask:0xf bound_ctrl:0
  v_add_f32_dpp v79, v79, v79 row_shr:8 row_mask:0xf bank_mask:0xf bound_ctrl:0
  v_add_f32_dpp v76, v76, v76 row_bcast:15 row_mask:0xa bank_mask:0xf
  v_add_f32_dpp v77, v77, v77 row_bcast:15 row_mask:0xa bank_mask:0xf
  v_add_f32_dpp v78, v78, v78 row_bcast:15 row_mask:0xa bank_mask:0xf
  v_add_f32_dpp v79, v79, v79 row_bcast:15 row_mask:0xa bank_mask:0xf
  s_mov_b32 s10, 0x80000000
  s_mov_b32 s11, 0x80000000
  v_cvt_pk_bf16_f32 v76, v76, v76
  v_cvt_pk_bf16_f32 v77, v77, v77
  v_cvt_pk_bf16_f32 v78, v78, v78
  v_cvt_pk_bf16_f32 v79, v79, v79
  s_mov_b64 exec, s[10:11]
  buffer_store_short v76, v74, s[56:59], 0 offen offset:0
  buffer_store_short v77, v74, s[56:59], 0 offen offset:1280
  buffer_store_short v78, v74, s[56:59], 0 offen offset:2560
  buffer_store_short v79, v74, s[56:59], 0 offen offset:3840
  s_or_b32 s10, s4, s5
  s_sub_u32 s11, s3, 5
  s_or_b32 s10, s10, s11
  s_cmp_lg_u32 s10, 0
  s_cbranch_scc1 L_noep
  v_mov_b32 v80, s8
  v_mov_b32 v81, 0
  s_mov_b32 s10, 2097152
  buffer_store_dword v80, v81, s[48:51], s10 offen sc1
L_noep:
  s_mov_b64 exec, -1
L_done:
L_end:
  s_endpgm
L_code_end:
.set CODE_BYTES, L_code_end - gated_mix__sliding_block_cached__dense_activation_relu__decode_kernel
.section .rodata,"a"
.p2align 6
.amdhsa_kernel gated_mix__sliding_block_cached__dense_activation_relu__decode_kernel
  .amdhsa_next_free_vgpr 256
  .amdhsa_next_free_sgpr 102
  .amdhsa_accum_offset 256
  .amdhsa_group_segment_fixed_size 0
  .amdhsa_kernarg_size 96
  .amdhsa_user_sgpr_count 2
  .amdhsa_user_sgpr_kernarg_segment_ptr 1
  .amdhsa_system_sgpr_workgroup_id_x 1
.end_amdhsa_kernel
```
